```python
import torch

def _softmax(x, axis=-1):
    return torch.softmax(x, dim=axis)
def _gelu(x):
    return torch.nn.functional.gelu(x, approximate="tanh")
def _silu(x):
    return torch.nn.functional.silu(x)
def _sigmoid(x):
    return torch.sigmoid(x)
def _layernorm(x, axis=-1, eps=1e-5):
    m = x.mean(dim=axis, keepdim=True)
    v = x.var(dim=axis, keepdim=True, unbiased=False)
    return (x - m) / torch.sqrt(v + eps)
def _scatter_add(tgt, idx, src, axis=0):
    return tgt.clone().index_add_(axis, idx, src)
def _segment_sum(src, seg, n):
    out = torch.zeros((n,) + src.shape[1:], dtype=src.dtype)
    return out.index_add_(0, seg, src)
def _pad(x, pw):
    flat = tuple(v for pair in reversed(pw) for v in pair)
    return torch.nn.functional.pad(x, flat)

kernel_name = 'gated_mix__sliding_block_cached__glu_gated_bilinear__decode'

def setup_inputs():

    _w = (lambda a: (lambda t: t.to(torch.bfloat16) if t.is_floating_point() else t)(torch.as_tensor(a)))
    def _A_setup():
        B, Sq, D = 2, 1, 512
        Hq, Hkv, Sk, Dh = 32, 32, 4096, 128
        assert Hq % Hkv == 0, (Hq, Hkv)
        return {
            "x": _w((lambda *s: torch.randn(*s, dtype=torch.bfloat16) * 0.05)(B, Sq, D)),
            "k_cache": _w((lambda *s: torch.randn(*s, dtype=torch.bfloat16) * 6.4)(B, Hkv, Sk, Dh)),
            "v_cache": _w((lambda *s: torch.randn(*s, dtype=torch.bfloat16) * 0.05)(B, Hkv, Sk, Dh)),
            "wq": _w((lambda *s: torch.randn(*s, dtype=torch.bfloat16) * 6.4)(D, Hq * Dh) * (D ** -0.5)),
            "wo": _w((lambda *s: torch.randn(*s, dtype=torch.bfloat16) * 0.05)(Hq * Dh, D) * ((Hq * Dh) ** -0.5)),
        }
    _A_in = _A_setup()

    def _B_setup():
        B, S, D, F = 2, 1, 512, 1376
        return {
            "x": _w((lambda *s: torch.randn(*s, dtype=torch.bfloat16) * 0.05)(B, S, D)),
            "w_gate": _w((lambda *s: torch.randn(*s, dtype=torch.bfloat16) * 0.4)(D, F) * (D ** -0.5)),
            "w_up": _w((lambda *s: torch.randn(*s, dtype=torch.bfloat16) * 0.4)(D, F) * (D ** -0.5)),
            "w_down": _w((lambda *s: torch.randn(*s, dtype=torch.bfloat16) * 0.4)(F, D) * (F ** -0.5)),
        }
    _B_in = _B_setup()

    return {
        "A_x": _A_in["x"],
        "A_k_cache": _A_in["k_cache"],
        "A_v_cache": _A_in["v_cache"],
        "A_wq": _A_in["wq"],
        "A_wo": _A_in["wo"],
        "B_x": _B_in["x"],
        "B_w_gate": _B_in["w_gate"],
        "B_w_up": _B_in["w_up"],
        "B_w_down": _B_in["w_down"],
        "gate_w": _w((lambda *s: torch.randn(*s, dtype=torch.bfloat16) * 0.05)(512) * 16.0),
    }

def reference(A_x, A_k_cache, A_v_cache, A_wq, A_wo, B_x, B_w_gate, B_w_up, B_w_down, gate_w):
    def _A_ref(x, k_cache, v_cache, wq, wo):
        B, Sq, D = x.shape
        Hq, Dh = 32, 128
        Hkv, Sk = k_cache.shape[1], k_cache.shape[2]
        W = min(4096, max(256, Sk // 4))
        rep = Hq // Hkv
        q = (lambda x, *d: x.permute(*d))((x @ wq).reshape(B, Sq, Hq, Dh), 0, 2, 1, 3)
        k = (lambda x, n, axis: torch.repeat_interleave(x, n, dim=axis))(k_cache[:, :, Sk - W:, :], rep, axis=1)
        v = (lambda x, n, axis: torch.repeat_interleave(x, n, dim=axis))(v_cache[:, :, Sk - W:, :], rep, axis=1)
        scores = torch.einsum("bhqd,bhkd->bhqk", q, k) * (Dh ** -0.5)
        p = _softmax(scores, axis=-1)
        o = torch.einsum("bhqk,bhkd->bhqd", p, v)
        return (lambda x, *d: x.permute(*d))(o, 0, 2, 1, 3).reshape(B, Sq, Hq * Dh) @ wo

    def _B_ref(x, w_gate, w_up, w_down):
        g = torch.einsum("bsd,df->bsf", x, w_gate)
        u = torch.einsum("bsd,df->bsf", x, w_up)
        h = g * u
        return torch.einsum("bsf,fd->bsd", h, w_down)

    x = A_x
    g = _sigmoid((x * gate_w).sum(-1, keepdims=True))
    a = _A_ref(x, A_k_cache, A_v_cache, A_wq, A_wo)
    b = _B_ref(x, B_w_gate, B_w_up, B_w_down)
    return g * a + (1 - g) * b
```

```asm
; @launch grid=(256,1,1) block=(640,1,1) lds=13824
.amdgcn_target "amdgcn-amd-amdhsa--gfx950"
.text
.globl gated_mix__sliding_block_cached__glu_gated_bilinear__decode_kernel
.p2align 12
.fill 832, 4, 0xbf810000
.p2align 8
.type gated_mix__sliding_block_cached__glu_gated_bilinear__decode_kernel,@function
gated_mix__sliding_block_cached__glu_gated_bilinear__decode_kernel:
    s_cmp_ge_u32 s2, 256
    s_cbranch_scc1 L_end
    s_load_dwordx2 s[20:21], s[0:1], 24
    s_load_dwordx2 s[8:9], s[0:1], 0
    s_load_dwordx2 s[44:45], s[0:1], 48
    s_load_dwordx2 s[46:47], s[0:1], 56
    s_load_dwordx2 s[12:13], s[0:1], 8
    s_load_dwordx2 s[16:17], s[0:1], 16
    s_load_dwordx2 s[40:41], s[0:1], 96
    s_load_dwordx2 s[32:33], s[0:1], 72
    s_load_dwordx2 s[28:29], s[0:1], 64
    s_load_dwordx2 s[24:25], s[0:1], 32
    s_load_dwordx2 s[36:37], s[0:1], 80
    v_lshrrev_b32 v8, 6, v0
    v_and_b32 v1, 63, v0
    v_readfirstlane_b32 s49, v8
    v_bfe_u32 v2, v0, 4, 2
    v_and_b32 v3, 15, v0
    s_and_b32 s53, s2, 7
    s_lshr_b32 s54, s2, 6
    s_lshl2_add_u32 s50, s53, s54
    s_bfe_u32 s52, s2, 0x30003
    s_mul_i32 s53, s50, 43
    s_lshr_b32 s60, s53, 3
    s_add_u32 s53, s53, 35
    s_lshr_b32 s53, s53, 3
    s_sub_u32 s63, s53, s60
    s_cmp_lt_u32 s49, 2
    s_cbranch_scc0 L_str
    s_setprio 3
    s_mov_b32 s10, 0x800
    s_mov_b32 s11, 0x20000
    s_mov_b32 s22, 0x400000
    s_mov_b32 s23, 0x20000
    s_lshl_b32 s53, s52, 6
    v_lshl_add_u32 v9, v2, 4, s53
    v_lshlrev_b32 v11, 7, v0
    v_and_b32 v11, 1024, v11
    v_lshl_add_u32 v11, v9, 1, v11
    s_cmp_eq_u32 s49, 1
    s_cbranch_scc1 L_auxf
    s_lshl_b32 s56, s50, 8
    v_lshlrev_b32 v10, 13, v9
    v_lshl_add_u32 v10, v3, 4, v10
    s_waitcnt lgkmcnt(0)
    buffer_load_dwordx4 v[32:35], v11, s[8:11], 0 offen
    buffer_load_dwordx4 v[36:39], v11, s[8:11], 0 offen offset:16
    buffer_load_dwordx4 v[52:55], v10, s[20:23], s56 offen nt
    s_addk_i32 s56, 0x2000
    buffer_load_dwordx4 v[56:59], v10, s[20:23], s56 offen nt
    s_addk_i32 s56, 0x2000
    buffer_load_dwordx4 v[60:63], v10, s[20:23], s56 offen nt
    s_addk_i32 s56, 0x2000
    buffer_load_dwordx4 v[64:67], v10, s[20:23], s56 offen nt
    s_addk_i32 s56, 0x2000
    buffer_load_dwordx4 v[68:71], v10, s[20:23], s56 offen nt
    s_addk_i32 s56, 0x2000
    buffer_load_dwordx4 v[72:75], v10, s[20:23], s56 offen nt
    s_addk_i32 s56, 0x2000
    buffer_load_dwordx4 v[76:79], v10, s[20:23], s56 offen nt
    s_addk_i32 s56, 0x2000
    buffer_load_dwordx4 v[80:83], v10, s[20:23], s56 offen nt
    s_addk_i32 s56, 0x2000
    buffer_load_dwordx4 v[84:87], v10, s[20:23], s56 offen nt
    s_addk_i32 s56, 0x2000
    buffer_load_dwordx4 v[88:91], v10, s[20:23], s56 offen nt
    s_addk_i32 s56, 0x2000
    buffer_load_dwordx4 v[92:95], v10, s[20:23], s56 offen nt
    s_addk_i32 s56, 0x2000
    buffer_load_dwordx4 v[96:99], v10, s[20:23], s56 offen nt
    s_addk_i32 s56, 0x2000
    buffer_load_dwordx4 v[100:103], v10, s[20:23], s56 offen nt
    s_addk_i32 s56, 0x2000
    buffer_load_dwordx4 v[104:107], v10, s[20:23], s56 offen nt
    s_addk_i32 s56, 0x2000
    buffer_load_dwordx4 v[108:111], v10, s[20:23], s56 offen nt
    s_addk_i32 s56, 0x2000
    buffer_load_dwordx4 v[112:115], v10, s[20:23], s56 offen nt
    s_branch L_auxc
L_auxf:
    v_and_b32 v21, 3, v0
    v_min_u32 v21, 2, v21
    v_bfe_u32 v20, v0, 2, 1
    v_mad_u32_u24 v21, v20, 3, v21
    v_min_u32 v21, s63, v21
    v_mul_u32_u24 v20, 2752, v9
    v_lshl_add_u32 v20, v21, 4, v20
    s_lshl_b32 s53, s60, 4
    s_addk_i32 s53, 2752
    v_add_u32 v20, s53, v20
    v_cmp_gt_u32 vcc, 8, v3
    v_mov_b32 v21, 0
    s_mov_b32 s90, 8256
    s_mov_b32 s91, 0
    s_waitcnt lgkmcnt(0)
    buffer_load_dwordx4 v[32:35], v11, s[8:11], 0 offen
    buffer_load_dwordx4 v[36:39], v11, s[8:11], 0 offen offset:16
    v_mov_b32 v18, s46
    v_mov_b32 v19, s47
    v_mov_b32 v16, s44
    v_mov_b32 v17, s45
    v_cndmask_b32 v18, v18, v16, vcc
    v_cndmask_b32 v19, v19, v17, vcc
    v_lshl_add_u64 v[18:19], v[18:19], 0, v[20:21]
    global_load_dwordx4 v[52:55], v[18:19], off offset:-2752 nt
    global_load_dwordx4 v[56:59], v[18:19], off offset:0 nt
    global_load_dwordx4 v[60:63], v[18:19], off offset:2752 nt
    v_lshl_add_u64 v[18:19], v[18:19], 0, s[90:91]
    global_load_dwordx4 v[64:67], v[18:19], off offset:-2752 nt
    global_load_dwordx4 v[68:71], v[18:19], off offset:0 nt
    global_load_dwordx4 v[72:75], v[18:19], off offset:2752 nt
    v_lshl_add_u64 v[18:19], v[18:19], 0, s[90:91]
    global_load_dwordx4 v[76:79], v[18:19], off offset:-2752 nt
    global_load_dwordx4 v[80:83], v[18:19], off offset:0 nt
    global_load_dwordx4 v[84:87], v[18:19], off offset:2752 nt
    v_lshl_add_u64 v[18:19], v[18:19], 0, s[90:91]
    global_load_dwordx4 v[88:91], v[18:19], off offset:-2752 nt
    global_load_dwordx4 v[92:95], v[18:19], off offset:0 nt
    global_load_dwordx4 v[96:99], v[18:19], off offset:2752 nt
    v_lshl_add_u64 v[18:19], v[18:19], 0, s[90:91]
    global_load_dwordx4 v[100:103], v[18:19], off offset:-2752 nt
    global_load_dwordx4 v[104:107], v[18:19], off offset:0 nt
    global_load_dwordx4 v[108:111], v[18:19], off offset:2752 nt
    v_lshl_add_u64 v[18:19], v[18:19], 0, s[90:91]
    global_load_dwordx4 v[112:115], v[18:19], off offset:-2752 nt
    s_branch L_auxc
L_str:
    s_sub_u32 s49, s49, 2
    s_mov_b32 s14, 0x4000000
    s_mov_b32 s15, 0x20000
    s_mov_b32 s18, 0x4000000
    s_mov_b32 s19, 0x20000
    s_lshr_b32 s51, s52, 2
    s_lshl_b32 s53, s51, 5
    s_add_u32 s53, s53, s50
    s_lshl_b32 s53, s53, 7
    s_and_b32 s54, s52, 3
    s_lshl3_add_u32 s54, s54, s49
    s_add_u32 s53, s53, s54
    s_addk_i32 s53, 96
    s_lshl_b32 s55, s53, 13
    s_add_u32 s4, s55, 4096
    v_lshlrev_b32 v12, 6, v0
    v_and_b32 v12, 0x300, v12
    v_and_b32 v13, 3, v0
    v_lshl_add_u32 v13, v2, 2, v13
    v_lshlrev_b32 v11, 4, v13
    v_add_u32 v12, v12, v11
    v_lshlrev_b32 v13, 4, v1
    s_mov_b64 exec, 0
    s_cmp_eq_u32 s49, 0
    s_cbranch_scc1 L_pad0
    s_cmp_eq_u32 s49, 1
    s_cbranch_scc1 L_pad1
    s_cmp_eq_u32 s49, 2
    s_cbranch_scc1 L_pad2
    s_cmp_eq_u32 s49, 3
    s_cbranch_scc1 L_pad3
    s_cmp_eq_u32 s49, 4
    s_cbranch_scc1 L_pad4
    s_cmp_eq_u32 s49, 5
    s_cbranch_scc1 L_pad5
L_back:
    s_mov_b64 exec, -1
    s_waitcnt lgkmcnt(0)
    s_branch L_str2
L_auxc:
    s_load_dword s48, s[40:41], 0
    s_mov_b32 s42, 0x1c2000
    s_mov_b32 s43, 0x20000
    s_mov_b32 s34, 0x400
    s_mov_b32 s35, 0x20000
    s_mov_b32 s59, 0x3fb8aa3b
    s_getreg_b32 s7, hwreg(HW_REG_XCC_ID, 0, 4)
    v_lshlrev_b32 v8, 4, v1
    v_and_b32 v9, 512, v8
    v_add_u32 v9, v9, v8
L_pad0:
    s_cbranch_execz L_back
    v_mov_b32 v10, v8
    s_lshl_b32 s6, s50, 14
    s_cmp_eq_u32 s49, 1
    s_cbranch_scc1 L_f1
    s_add_u32 s6, s6, 4096
    s_lshr_b32 s53, s52, 2
    s_branch L_f2
L_f1:
    v_bfe_u32 v8, v0, 2, 1
    v_lshlrev_b32 v8, 9, v8
    v_bfe_u32 v11, v0, 3, 1
    v_lshl_add_u32 v8, v11, 8, v8
    v_lshl_add_u32 v8, v2, 6, v8
    v_and_b32 v11, 3, v0
    v_lshl_add_u32 v8, v11, 4, v8
    s_add_u32 s6, s6, 528384
    s_and_b32 s53, s52, 1
L_f2:
    s_lshl_b32 s56, s52, 11
    s_add_u32 s56, s56, s6
    s_lshl_b32 s53, s53, 9
    s_add_u32 s6, s6, s53
    v_and_b32 v16, 1, v0
    v_lshlrev_b32 v16, 4, v16
    v_mov_b32 v17, 0xffff
    v_lshlrev_b32 v16, v16, v17
    v_bfe_u32 v17, v0, 1, 2
    v_cmp_eq_u32 s[90:91], 0, v17
    v_cmp_eq_u32 s[92:93], 1, v17
    v_cmp_eq_u32 s[94:95], 2, v17
    v_cmp_eq_u32 s[96:97], 3, v17
    v_cndmask_b32 v4, 0, v16, s[90:91]
    v_cndmask_b32 v5, 0, v16, s[92:93]
    v_cndmask_b32 v6, 0, v16, s[94:95]
    v_cndmask_b32 v7, 0, v16, s[96:97]
    v_mov_b32 v18, 0x0c0c0c0c
    s_mov_b32 s53, 0x01000100
    s_mov_b32 s54, 0x03020302
    v_bfi_b32 v20, v4, s53, v18
    v_bfi_b32 v24, v4, s54, v18
    v_bfi_b32 v21, v5, s53, v18
    v_bfi_b32 v25, v5, s54, v18
    v_bfi_b32 v22, v6, s53, v18
    v_bfi_b32 v26, v6, s54, v18
    v_bfi_b32 v23, v7, s53, v18
    v_bfi_b32 v27, v7, s54, v18
    s_add_u32 s54, s6, 4096
    s_add_u32 s55, s6, 8192
    s_add_u32 s4, s6, 12288
    s_mov_b32 s57, 0
    s_waitcnt vmcnt(16)
    v_perm_b32 v40, v32, v32, v20
    v_perm_b32 v41, v32, v32, v21
    v_perm_b32 v42, v32, v32, v22
    v_perm_b32 v43, v32, v32, v23
    s_waitcnt vmcnt(14)
    s_nop 0
    v_mfma_f32_16x16x32_bf16 v[12:15], v[40:43], v[52:55], 0
    v_perm_b32 v44, v32, v32, v24
    v_perm_b32 v45, v32, v32, v25
    v_perm_b32 v46, v32, v32, v26
    v_perm_b32 v47, v32, v32, v27
    s_nop 1
    v_mfma_f32_16x16x32_bf16 v[12:15], v[44:47], v[56:59], v[12:15]
    v_perm_b32 v48, v33, v33, v20
    v_perm_b32 v49, v33, v33, v21
    v_perm_b32 v50, v33, v33, v22
    v_perm_b32 v51, v33, v33, v23
    s_waitcnt vmcnt(12)
    s_nop 0
    v_mfma_f32_16x16x32_bf16 v[12:15], v[48:51], v[60:63], v[12:15]
    v_perm_b32 v40, v33, v33, v24
    v_perm_b32 v41, v33, v33, v25
    v_perm_b32 v42, v33, v33, v26
    v_perm_b32 v43, v33, v33, v27
    s_nop 1
    v_mfma_f32_16x16x32_bf16 v[12:15], v[40:43], v[64:67], v[12:15]
    v_perm_b32 v44, v34, v34, v20
    v_perm_b32 v45, v34, v34, v21
    v_perm_b32 v46, v34, v34, v22
    v_perm_b32 v47, v34, v34, v23
    s_waitcnt vmcnt(10)
    s_barrier
    v_mfma_f32_16x16x32_bf16 v[12:15], v[44:47], v[68:71], v[12:15]
    v_perm_b32 v48, v34, v34, v24
    v_perm_b32 v49, v34, v34, v25
    v_perm_b32 v50, v34, v34, v26
    v_perm_b32 v51, v34, v34, v27
    s_nop 1
    v_mfma_f32_16x16x32_bf16 v[12:15], v[48:51], v[72:75], v[12:15]
    v_perm_b32 v40, v35, v35, v20
    v_perm_b32 v41, v35, v35, v21
    v_perm_b32 v42, v35, v35, v22
    v_perm_b32 v43, v35, v35, v23
    s_waitcnt vmcnt(8)
    s_nop 0
    v_mfma_f32_16x16x32_bf16 v[12:15], v[40:43], v[76:79], v[12:15]
    v_perm_b32 v44, v35, v35, v24
    v_perm_b32 v45, v35, v35, v25
    v_perm_b32 v46, v35, v35, v26
    v_perm_b32 v47, v35, v35, v27
    s_nop 1
    v_mfma_f32_16x16x32_bf16 v[12:15], v[44:47], v[80:83], v[12:15]
    v_perm_b32 v48, v36, v36, v20
    v_perm_b32 v49, v36, v36, v21
    v_perm_b32 v50, v36, v36, v22
    v_perm_b32 v51, v36, v36, v23
    s_waitcnt vmcnt(6)
    s_nop 0
    v_mfma_f32_16x16x32_bf16 v[12:15], v[48:51], v[84:87], v[12:15]
    v_perm_b32 v40, v36, v36, v24
    v_perm_b32 v41, v36, v36, v25
    v_perm_b32 v42, v36, v36, v26
    v_perm_b32 v43, v36, v36, v27
    s_nop 1
    v_mfma_f32_16x16x32_bf16 v[12:15], v[40:43], v[88:91], v[12:15]
    v_perm_b32 v44, v37, v37, v20
    v_perm_b32 v45, v37, v37, v21
    v_perm_b32 v46, v37, v37, v22
    v_perm_b32 v47, v37, v37, v23
    s_waitcnt vmcnt(4)
    s_nop 0
    v_mfma_f32_16x16x32_bf16 v[12:15], v[44:47], v[92:95], v[12:15]
    v_perm_b32 v48, v37, v37, v24
    v_perm_b32 v49, v37, v37, v25
    v_perm_b32 v50, v37, v37, v26
    v_perm_b32 v51, v37, v37, v27
    s_nop 1
    v_mfma_f32_16x16x32_bf16 v[12:15], v[48:51], v[96:99], v[12:15]
    v_perm_b32 v40, v38, v38, v20
    v_perm_b32 v41, v38, v38, v21
    v_perm_b32 v42, v38, v38, v22
    v_perm_b32 v43, v38, v38, v23
    s_waitcnt vmcnt(2)
    s_nop 0
    v_mfma_f32_16x16x32_bf16 v[12:15], v[40:43], v[100:103], v[12:15]
    v_perm_b32 v44, v38, v38, v24
    v_perm_b32 v45, v38, v38, v25
    v_perm_b32 v46, v38, v38, v26
    v_perm_b32 v47, v38, v38, v27
    s_nop 1
    v_mfma_f32_16x16x32_bf16 v[12:15], v[44:47], v[104:107], v[12:15]
    v_perm_b32 v48, v39, v39, v20
    v_perm_b32 v49, v39, v39, v21
    v_perm_b32 v50, v39, v39, v22
    v_perm_b32 v51, v39, v39, v23
    s_waitcnt vmcnt(0)
    s_nop 0
    v_mfma_f32_16x16x32_bf16 v[12:15], v[48:51], v[108:111], v[12:15]
    v_perm_b32 v40, v39, v39, v24
L_pad1:
    s_cbranch_execz L_back
    v_perm_b32 v41, v39, v39, v25
    v_perm_b32 v42, v39, v39, v26
    v_perm_b32 v43, v39, v39, v27
    s_nop 1
    v_mfma_f32_16x16x32_bf16 v[12:15], v[40:43], v[112:115], v[12:15]
    s_waitcnt lgkmcnt(0)
    s_add_u32 s48, s48, 0x9e3779b9
    s_add_u32 s53, s48, s7
    v_mov_b32 v17, s48
    v_mov_b32 v19, s53
    v_mov_b32 v21, s48
    v_mov_b32 v23, s53
    s_nop 0
    v_mov_b32 v16, v12
    v_mov_b32 v18, v13
    v_mov_b32 v20, v14
    v_mov_b32 v22, v15
    buffer_store_dwordx4 v[16:19], v8, s[40:43], s56 offen
    buffer_store_dwordx4 v[20:23], v8, s[40:43], s56 offen offset:1024
    s_cmp_eq_u32 s49, 0
    s_cbranch_scc1 L_pdel
    buffer_load_dwordx4 v[116:119], v10, s[8:11], 0 offen
    buffer_load_dwordx4 v[120:123], v10, s[8:11], 0 offen offset:1024
    buffer_load_dwordx4 v[124:127], v10, s[32:35], 0 offen
    s_barrier
    s_waitcnt vmcnt(0)
    v_lshlrev_b32 v12, 16, v116
    v_and_b32 v13, 0xffff0000, v116
    v_lshlrev_b32 v14, 16, v124
    v_and_b32 v15, 0xffff0000, v124
    v_pk_mul_f32 v[12:13], v[12:13], v[14:15]
    v_cvt_pk_bf16_f32 v12, v12, v13
    v_and_b32 v13, 0xffff0000, v12
    v_lshlrev_b32 v12, 16, v12
    v_add_f32 v28, v12, v13
    v_lshlrev_b32 v12, 16, v117
    v_and_b32 v13, 0xffff0000, v117
    v_lshlrev_b32 v14, 16, v125
    v_and_b32 v15, 0xffff0000, v125
    v_pk_mul_f32 v[12:13], v[12:13], v[14:15]
    v_cvt_pk_bf16_f32 v12, v12, v13
    v_and_b32 v13, 0xffff0000, v12
    v_lshlrev_b32 v12, 16, v12
    v_add_f32 v12, v12, v13
    v_add_f32 v28, v28, v12
    v_lshlrev_b32 v12, 16, v118
    v_and_b32 v13, 0xffff0000, v118
    v_lshlrev_b32 v14, 16, v126
    v_and_b32 v15, 0xffff0000, v126
    v_pk_mul_f32 v[12:13], v[12:13], v[14:15]
    v_cvt_pk_bf16_f32 v12, v12, v13
    v_and_b32 v13, 0xffff0000, v12
    v_lshlrev_b32 v12, 16, v12
    v_add_f32 v12, v12, v13
    v_add_f32 v28, v28, v12
    v_lshlrev_b32 v12, 16, v119
    v_and_b32 v13, 0xffff0000, v119
    v_lshlrev_b32 v14, 16, v127
    v_and_b32 v15, 0xffff0000, v127
    v_pk_mul_f32 v[12:13], v[12:13], v[14:15]
    v_cvt_pk_bf16_f32 v12, v12, v13
    v_and_b32 v13, 0xffff0000, v12
    v_lshlrev_b32 v12, 16, v12
    v_add_f32 v12, v12, v13
    v_add_f32 v28, v28, v12
    v_lshlrev_b32 v12, 16, v120
    v_and_b32 v13, 0xffff0000, v120
    v_lshlrev_b32 v14, 16, v124
    v_and_b32 v15, 0xffff0000, v124
    v_pk_mul_f32 v[12:13], v[12:13], v[14:15]
    v_cvt_pk_bf16_f32 v12, v12, v13
    v_and_b32 v13, 0xffff0000, v12
    v_lshlrev_b32 v12, 16, v12
    v_add_f32 v29, v12, v13
    v_lshlrev_b32 v12, 16, v121
    v_and_b32 v13, 0xffff0000, v121
    v_lshlrev_b32 v14, 16, v125
    v_and_b32 v15, 0xffff0000, v125
    v_pk_mul_f32 v[12:13], v[12:13], v[14:15]
    v_cvt_pk_bf16_f32 v12, v12, v13
    v_and_b32 v13, 0xffff0000, v12
    v_lshlrev_b32 v12, 16, v12
    v_add_f32 v12, v12, v13
    v_add_f32 v29, v29, v12
    v_lshlrev_b32 v12, 16, v122
    v_and_b32 v13, 0xffff0000, v122
    v_lshlrev_b32 v14, 16, v126
    v_and_b32 v15, 0xffff0000, v126
    v_pk_mul_f32 v[12:13], v[12:13], v[14:15]
    v_cvt_pk_bf16_f32 v12, v12, v13
    v_and_b32 v13, 0xffff0000, v12
    v_lshlrev_b32 v12, 16, v12
    v_add_f32 v12, v12, v13
    v_add_f32 v29, v29, v12
    v_lshlrev_b32 v12, 16, v123
    v_and_b32 v13, 0xffff0000, v123
    v_lshlrev_b32 v14, 16, v127
    v_and_b32 v15, 0xffff0000, v127
    v_pk_mul_f32 v[12:13], v[12:13], v[14:15]
    v_cvt_pk_bf16_f32 v12, v12, v13
    v_and_b32 v13, 0xffff0000, v12
    v_lshlrev_b32 v12, 16, v12
    v_add_f32 v12, v12, v13
    v_add_f32 v29, v29, v12
    s_nop 1
    v_permlane32_swap_b32 v28, v29
    v_add_f32 v28, v28, v29
    s_nop 1
    v_add_f32_dpp v28, v28, v28 quad_perm:[1,0,3,2] row_mask:0xf bank_mask:0xf
    s_nop 1
    v_add_f32_dpp v28, v28, v28 quad_perm:[2,3,0,1] row_mask:0xf bank_mask:0xf
    s_nop 1
    v_add_f32_dpp v28, v28, v28 row_half_mirror row_mask:0xf bank_mask:0xf
    s_nop 1
    v_add_f32_dpp v28, v28, v28 row_mirror row_mask:0xf bank_mask:0xf
    v_mov_b32 v29, v28
    s_nop 1
    v_permlane16_swap_b32 v28, v29
    v_add_f32 v28, v28, v29
    v_cvt_pk_bf16_f32 v28, v28, v28
    v_lshlrev_b32 v28, 16, v28
    v_mul_f32 v28, s59, v28
    v_exp_f32 v28, -v28
    s_nop 0
    v_add_f32 v28, 1.0, v28
    v_rcp_f32 v28, v28
    s_nop 0
    v_cvt_pk_bf16_f32 v28, v28, v28
    v_lshlrev_b32 v28, 16, v28
    v_sub_f32 v29, 1.0, v28
    v_cvt_pk_bf16_f32 v29, v29, v29
    v_lshlrev_b32 v29, 16, v29
    v_lshrrev_b32 v30, 5, v1
    v_lshlrev_b32 v31, 2, v30
    ds_write_b32 v31, v28 offset:256
    v_mov_b32 v28, v29
    v_and_b32 v31, 8, v0
    v_cmp_eq_u32 vcc, 0, v31
    v_permlane32_swap_b32 v28, v29
    s_nop 0
    v_cndmask_b32 v29, v29, v28, vcc
    s_branch L_p1
L_pdel:
    v_mov_b32 v12, 0
    v_mov_b32 v13, 0
    v_mov_b32 v14, 0
    v_mov_b32 v15, 0
    ds_write_b128 v12, v[12:15] offset:288
    s_waitcnt vmcnt(0)
L_p1:
    s_add_u32 s57, s57, 1
    s_cmp_gt_u32 s57, 200000
    s_cbranch_scc1 L_fin
    s_cmp_eq_u32 s57, 4
    s_cbranch_scc0 L_p1a
    buffer_store_dwordx4 v[16:19], v8, s[40:43], s56 offen sc1
    buffer_store_dwordx4 v[20:23], v8, s[40:43], s56 offen offset:1024 sc1
L_p1a:
    buffer_load_dwordx4 v[52:55], v9, s[40:43], s6 offen offset:0 sc1
    buffer_load_dwordx4 v[56:59], v9, s[40:43], s6 offen offset:2048 sc1
    buffer_load_dwordx4 v[60:63], v9, s[40:43], s54 offen offset:0 sc1
    buffer_load_dwordx4 v[64:67], v9, s[40:43], s54 offen offset:2048 sc1
    buffer_load_dwordx4 v[68:71], v9, s[40:43], s55 offen offset:0 sc1
    buffer_load_dwordx4 v[72:75], v9, s[40:43], s55 offen offset:2048 sc1
    buffer_load_dwordx4 v[76:79], v9, s[40:43], s4 offen offset:0 sc1
    buffer_load_dwordx4 v[80:83], v9, s[40:43], s4 offen offset:2048 sc1
    s_waitcnt vmcnt(0)
    v_xor_b32 v12, s48, v53
    v_bitop3_b32 v12, v57, s48, v12 bitop3:0xbe
    v_bitop3_b32 v12, v61, s48, v12 bitop3:0xbe
    v_bitop3_b32 v12, v65, s48, v12 bitop3:0xbe
    v_bitop3_b32 v12, v69, s48, v12 bitop3:0xbe
    v_bitop3_b32 v12, v73, s48, v12 bitop3:0xbe
    v_bitop3_b32 v12, v77, s48, v12 bitop3:0xbe
    v_bitop3_b32 v12, v81, s48, v12 bitop3:0xbe
    v_subrev_u32 v55, s48, v55
    v_subrev_u32 v59, s48, v59
    v_subrev_u32 v63, s48, v63
    v_subrev_u32 v67, s48, v67
    v_subrev_u32 v71, s48, v71
L_pad2:
    s_cbranch_execz L_back
    v_subrev_u32 v75, s48, v75
    v_subrev_u32 v79, s48, v79
    v_subrev_u32 v83, s48, v83
    v_max3_u32 v13, v55, v59, v63
    v_max3_u32 v13, v13, v67, v71
    v_max3_u32 v13, v13, v75, v79
    v_max3_u32 v13, v13, v83, v83
    v_min3_u32 v14, v55, v59, v63
    v_min3_u32 v14, v14, v67, v71
    v_min3_u32 v14, v14, v75, v79
    v_min3_u32 v14, v14, v83, v83
    v_lshrrev_b32 v15, 4, v13
    v_or_b32 v12, v12, v15
    v_cmp_ne_u32 vcc, 0, v12
    s_nop 4
    s_cbranch_vccnz L_p1
    v_cmp_ne_u32 vcc, v13, v14
    s_nop 1
    s_cmp_lg_u64 vcc, 0
    s_cselect_b32 s53, 1, 0
    s_cbranch_scc0 L_p1b
    buffer_store_dwordx4 v[16:19], v8, s[40:43], s56 offen sc1
    buffer_store_dwordx4 v[20:23], v8, s[40:43], s56 offen offset:1024 sc1
L_p1b:
    v_add_f32 v52, v52, v68
    v_add_f32 v54, v54, v70
    v_add_f32 v56, v56, v72
    v_add_f32 v58, v58, v74
    v_add_f32 v60, v60, v76
    v_add_f32 v62, v62, v78
    v_add_f32 v64, v64, v80
    v_add_f32 v66, v66, v82
    v_add_f32 v52, v52, v60
    v_add_f32 v54, v54, v62
    v_add_f32 v56, v56, v64
    v_add_f32 v58, v58, v66
    v_add_f32 v16, v52, v56
    v_add_f32 v17, v54, v58
    v_cvt_pk_bf16_f32 v16, v16, v17
    s_cmp_eq_u32 s49, 0
    s_cbranch_scc0 L_hh
    v_lshlrev_b32 v10, 4, v3
    v_bfe_u32 v11, v0, 4, 1
    v_lshl_add_u32 v10, v11, 3, v10
    v_bfe_u32 v11, v0, 5, 1
    v_lshl_add_u32 v10, v11, 2, v10
    ds_write_b32 v10, v16 offset:0
    v_mov_b32 v11, 0
    v_mov_b32 v12, s53
    ds_write_b32 v11, v12 offset:272
    s_branch L_adone
L_hh:
    v_mov_b32 v17, v16
    s_nop 1
    v_permlane16_swap_b32 v16, v17
    v_lshlrev_b32 v18, 16, v16
    v_lshlrev_b32 v19, 16, v17
    v_and_b32 v16, 0xffff0000, v16
    v_and_b32 v17, 0xffff0000, v17
    v_mul_f32 v18, v18, v19
    v_mul_f32 v16, v16, v17
    v_cvt_pk_bf16_f32 v16, v18, v16
    v_lshlrev_b32 v18, 16, v16
    v_and_b32 v16, 0xffff0000, v16
    v_mul_f32 v18, v18, v29
    v_mul_f32 v16, v16, v29
    v_cvt_pk_bf16_f32 v18, v18, v18
    v_cvt_pk_bf16_f32 v19, v16, v16
    v_lshlrev_b32 v30, 3, v30
    v_and_b32 v31, 3, v0
    v_lshl_add_u32 v30, v31, 5, v30
    v_and_b32 v31, 4, v0
    v_lshl_add_u32 v30, v31, 2, v30
    v_and_b32 v31, 8, v0
    v_lshl_add_u32 v30, v31, 4, v30
    ds_write_b64 v30, v[18:19] offset:512
L_adone:
    s_waitcnt lgkmcnt(0)
    s_barrier
    s_branch L_fin
L_str2:
    s_load_dword s48, s[40:41], 0
    s_mov_b32 s26, 0x400000
    s_mov_b32 s27, 0x20000
    s_mov_b32 s30, 0x158000
    s_mov_b32 s31, 0x20000
    s_mov_b32 s38, 0x800
    s_mov_b32 s39, 0x20000
    s_mov_b32 s42, 0x1c2000
    s_mov_b32 s43, 0x20000
    s_and_b32 s61, s52, 1
    s_lshr_b32 s62, s52, 1
    s_sub_u32 s53, s63, s61
    s_cmp_eq_u32 s53, 3
    s_cselect_b32 s63, 4, 6
    v_and_b32 v16, 1, v0
    v_lshlrev_b32 v16, 4, v16
    v_mov_b32 v17, 0xffff
    v_lshlrev_b32 v16, v16, v17
    v_bfe_u32 v17, v0, 1, 2
    v_cmp_eq_u32 s[90:91], 0, v17
    v_cmp_eq_u32 s[92:93], 1, v17
    v_cmp_eq_u32 s[94:95], 2, v17
    v_cmp_eq_u32 s[96:97], 3, v17
    v_cndmask_b32 v4, 0, v16, s[90:91]
    v_cndmask_b32 v5, 0, v16, s[92:93]
    v_cndmask_b32 v6, 0, v16, s[94:95]
    v_cndmask_b32 v7, 0, v16, s[96:97]
    v_or_b32 v134, v4, v6
    v_or_b32 v135, v5, v7
    s_lshl1_add_u32 s53, s50, s61
    s_lshl3_add_u32 s53, s53, s49
    s_lshl_b32 s53, s53, 3
    s_lshl_b32 s54, s62, 8
    v_lshl_add_u32 v10, v3, 4, s54
    v_lshl_add_u32 v9, v2, 1, s53
    v_lshl_add_u32 v9, v9, 10, v10
    s_mul_i32 s53, s61, 3
    s_add_u32 s53, s53, s60
    s_lshl_b32 s54, s49, 2
    s_lshl3_add_u32 s53, s53, s54
    s_cmp_lt_u32 s49, s63
    s_cselect_b32 s53, s53, 4096
    v_add_u32 v8, s53, v2
    v_lshl_add_u32 v8, v8, 10, v10
    v_bfe_u32 v14, v0, 3, 1
    v_and_b32 v15, 3, v0
    v_lshlrev_b32 v15, 4, v15
    v_add_u32 v16, s54, v2
    v_lshlrev_b32 v17, 2, v16
    v_lshl_add_u32 v132, v14, 7, v17
    v_lshlrev_b32 v133, 2, v14
    v_lshl_add_u32 v16, v16, 6, v15
    v_lshl_add_u32 v15, v14, 6, v15
    v_lshl_add_u32 v14, v14, 12, v16
    v_lshrrev_b32 v16, 2, v3
    v_mov_b32 v17, 288
    v_cmp_eq_u32 s[90:91], 0, v16
    v_cmp_eq_u32 s[92:93], 1, v16
    v_cmp_eq_u32 s[94:95], 2, v16
    v_cmp_eq_u32 s[96:97], 3, v16
    v_cndmask_b32 v136, v17, v11, s[90:91]
    v_cndmask_b32 v137, v17, v11, s[92:93]
    v_cndmask_b32 v138, v17, v11, s[94:95]
    v_cndmask_b32 v139, v17, v11, s[96:97]
    s_mul_i32 s53, s49, 544
    v_lshl_add_u32 v140, v3, 5, s53
    v_and_b32 v16, 7, v0
    v_lshrrev_b32 v17, 3, v1
    s_lshl_b32 s53, s49, 3
    v_add_u32 v17, s53, v17
    v_mul_u32_u24 v141, 544, v16
    v_lshl_add_u32 v141, v17, 3, v141
    v_lshlrev_b32 v142, 3, v16
    s_lshl_b32 s5, s50, 13
    s_add_u32 s5, s5, 1052672
    s_lshl_b32 s6, s50, 7
    s_add_u32 s6, s6, 1314816
    s_lshl_b32 s53, s51, 12
    s_and_b32 s54, s52, 3
    s_lshl4_add_u32 s53, s54, s53
    v_lshl_add_u32 v143, v17, 6, s53
    s_lshl4_add_u32 s53, s52, s6
    s_sub_u32 s53, s53, s5
    v_mov_b32 v16, s53
    v_cmp_eq_u32 vcc, 1, v1
    s_nop 1
    v_cndmask_b32 v143, v143, v16, vcc
    s_lshl_b32 s53, s61, 11
    v_add_u32 v14, s53, v14
    s_sub_u32 s53, s6, s5
    v_add_u32 v15, s53, v15
    v_and_b32 v16, 4, v0
    v_cmp_eq_u32 vcc, 0, v16
    s_nop 1
    v_cndmask_b32 v14, v15, v14, vcc
    v_and_b32 v10, 1, v2
    v_lshlrev_b32 v10, 4, v10
    v_lshl_add_u32 v10, v3, 5, v10
    v_lshrrev_b32 v16, 1, v2
    v_lshl_add_u32 v16, v16, 9, v10
    s_lshl_b32 s53, s49, 10
    v_add_u32 v144, s53, v16
    s_lshl_b32 s53, s49, 9
    v_lshl_add_u32 v145, v1, 3, s53
L_pad3:
    s_cbranch_execz L_back
    v_lshlrev_b32 v147, 4, v1
    s_lshl1_add_u32 s53, s62, s49
    s_lshl_b32 s53, s53, 5
    s_add_u32 s53, s53, s50
    s_lshl1_add_u32 s53, s53, s61
    s_lshl_b32 s53, s53, 10
    s_add_u32 s96, s53, 1318912
    s_and_b32 s53, s2, 7
    s_bfe_u32 s54, s2, 0x40003
    s_lshl4_add_u32 s53, s53, s54
    s_lshr_b32 s54, s2, 7
    s_lshr_b32 s56, s53, 5
    s_lshl1_add_u32 s56, s56, s54
    s_lshl_b32 s56, s56, 11
    s_and_b32 s58, s53, 31
    s_add_u32 s56, s56, s58
    s_lshl_b32 s56, s56, 5
    s_add_u32 s56, s56, 1318912
    s_lshl_b32 s54, s54, 7
    s_add_u32 s53, s53, s54
    s_lshl_b32 s97, s53, 3
    v_lshrrev_b32 v16, 1, v1
    v_lshlrev_b32 v16, 10, v16
    v_and_b32 v17, 1, v0
    v_lshl_add_u32 v146, v17, 4, v16
    s_mov_b32 s58, 0x3db504f3
    s_mov_b32 s59, 0x3fb8aa3b
    s_lshl_b32 s53, s49, 3
    v_mov_b32 v11, s53
    v_mov_b32 v10, 0
    s_mov_b32 s57, 0
    s_cmp_eq_u32 s49, 0
    s_cselect_b32 s90, 2, 0
    s_mov_b32 s91, 0x01010101
    s_or_b32 s90, s90, s91
    s_barrier
    buffer_load_dwordx4 v[48:51], v12, s[12:15], s55 offen offset:0 nt
    buffer_load_dwordx4 v[52:55], v12, s[12:15], s55 offen offset:1024 nt
    buffer_load_dwordx4 v[56:59], v12, s[12:15], s55 offen offset:2048 nt
    buffer_load_dwordx4 v[60:63], v12, s[12:15], s55 offen offset:3072 nt
    buffer_load_dwordx4 v[64:67], v12, s[12:15], s4 offen offset:0 nt
    s_waitcnt vmcnt(4)
    buffer_load_dwordx4 v[68:71], v12, s[12:15], s4 offen offset:1024 nt
    s_waitcnt vmcnt(4)
    buffer_load_dwordx4 v[72:75], v12, s[12:15], s4 offen offset:2048 nt
    s_waitcnt vmcnt(4)
    buffer_load_dwordx4 v[76:79], v12, s[12:15], s4 offen offset:3072 nt
    s_waitcnt vmcnt(4)
    buffer_load_dwordx4 v[80:83], v13, s[16:19], s55 offen offset:0 nt
    s_waitcnt vmcnt(4)
    buffer_load_dwordx4 v[84:87], v13, s[16:19], s55 offen offset:1024 nt
    s_waitcnt vmcnt(4)
    buffer_load_dwordx4 v[88:91], v13, s[16:19], s55 offen offset:2048 nt
    s_waitcnt vmcnt(4)
    buffer_load_dwordx4 v[92:95], v13, s[16:19], s55 offen offset:3072 nt
    s_waitcnt vmcnt(4)
    buffer_load_dwordx4 v[96:99], v13, s[16:19], s4 offen offset:0 nt
    s_waitcnt lgkmcnt(0)
    s_add_u32 s48, s48, 0x9e3779b9
    v_mov_b32 v21, s48
    v_mov_b32 v23, s48
    s_barrier
    ds_read_b128 v[32:35], v136 offset:0
    ds_read_b128 v[36:39], v137 offset:0
    ds_read_b128 v[40:43], v138 offset:0
    ds_read_b128 v[44:47], v139 offset:0
    ds_read_b32 v31, v10 offset:272
    buffer_load_dwordx4 v[100:103], v13, s[16:19], s4 offen offset:1024 nt
    buffer_load_dwordx4 v[104:107], v13, s[16:19], s4 offen offset:2048 nt
    buffer_load_dwordx4 v[108:111], v13, s[16:19], s4 offen offset:3072 nt
    s_waitcnt lgkmcnt(4)
    v_mfma_f32_16x16x32_bf16 v[16:19], v[48:51], v[32:35], 0
    v_mfma_f32_16x16x32_bf16 v[24:27], v[64:67], v[32:35], 0
    s_waitcnt lgkmcnt(3)
    v_mfma_f32_16x16x32_bf16 v[16:19], v[52:55], v[36:39], v[16:19]
    v_mfma_f32_16x16x32_bf16 v[24:27], v[68:71], v[36:39], v[24:27]
    s_waitcnt lgkmcnt(2)
    v_mfma_f32_16x16x32_bf16 v[16:19], v[56:59], v[40:43], v[16:19]
    v_mfma_f32_16x16x32_bf16 v[24:27], v[72:75], v[40:43], v[24:27]
    s_waitcnt lgkmcnt(1)
    v_mfma_f32_16x16x32_bf16 v[16:19], v[60:63], v[44:47], v[16:19]
    v_mfma_f32_16x16x32_bf16 v[24:27], v[76:79], v[44:47], v[24:27]
    s_nop 6
    v_mov_b32_dpp v28, v16 quad_perm:[0,0,0,0] row_mask:0xf bank_mask:0xf
    v_mov_b32_dpp v29, v24 quad_perm:[0,0,0,0] row_mask:0xf bank_mask:0xf
    v_add_f32_dpp v28, v17, v28 quad_perm:[1,1,1,1] row_mask:0xf bank_mask:0xf
    v_add_f32_dpp v29, v25, v29 quad_perm:[1,1,1,1] row_mask:0xf bank_mask:0xf
    v_add_f32_dpp v28, v18, v28 quad_perm:[2,2,2,2] row_mask:0xf bank_mask:0xf
    v_add_f32_dpp v29, v26, v29 quad_perm:[2,2,2,2] row_mask:0xf bank_mask:0xf
    v_add_f32_dpp v28, v19, v28 quad_perm:[3,3,3,3] row_mask:0xf bank_mask:0xf
    v_add_f32_dpp v29, v27, v29 quad_perm:[3,3,3,3] row_mask:0xf bank_mask:0xf
    v_cvt_pk_bf16_f32 v28, v28, v29
    v_and_b32 v29, 0xffff0000, v28
    v_lshlrev_b32 v28, 16, v28
    v_mul_f32 v28, s58, v28
    v_mul_f32 v29, s58, v29
    v_cvt_pk_bf16_f32 v28, v28, v29
    v_and_b32 v29, 0xffff0000, v28
    v_lshlrev_b32 v28, 16, v28
    v_max_f32 v24, v28, v29
    s_nop 1
    v_max_f32_dpp v24, v24, v24 row_ror:4 row_mask:0xf bank_mask:0xf
    s_nop 1
    v_max_f32_dpp v24, v24, v24 row_ror:8 row_mask:0xf bank_mask:0xf
    v_mov_b32 v26, v24
    s_nop 1
    v_permlane16_swap_b32 v24, v26
    v_max_f32 v24, v24, v26
    v_mov_b32 v26, v24
    s_nop 1
    v_permlane32_swap_b32 v24, v26
    v_max_f32 v24, v24, v26
    v_sub_f32 v28, v28, v24
    v_sub_f32 v29, v29, v24
    v_mul_f32 v28, s59, v28
    v_mul_f32 v29, s59, v29
    v_exp_f32 v28, v28
    v_exp_f32 v29, v29
    v_cvt_pk_bf16_f32 v26, v28, v28
    v_cvt_pk_bf16_f32 v27, v29, v29
    v_add_f32 v25, v28, v29
    v_and_b32_dpp v48, v26, v134 row_newbcast:0 row_mask:0xf bank_mask:0xf
    v_and_b32_dpp v49, v26, v135 row_newbcast:0 row_mask:0xf bank_mask:0xf
    v_and_b32_dpp v50, v26, v134 row_newbcast:4 row_mask:0xf bank_mask:0xf
    v_and_b32_dpp v51, v26, v135 row_newbcast:4 row_mask:0xf bank_mask:0xf
    v_and_b32_dpp v52, v26, v134 row_newbcast:8 row_mask:0xf bank_mask:0xf
    v_and_b32_dpp v53, v26, v135 row_newbcast:8 row_mask:0xf bank_mask:0xf
    v_and_b32_dpp v54, v26, v134 row_newbcast:12 row_mask:0xf bank_mask:0xf
    v_and_b32_dpp v55, v26, v135 row_newbcast:12 row_mask:0xf bank_mask:0xf
    v_and_b32_dpp v56, v27, v134 row_newbcast:0 row_mask:0xf bank_mask:0xf
    v_and_b32_dpp v57, v27, v135 row_newbcast:0 row_mask:0xf bank_mask:0xf
    v_and_b32_dpp v58, v27, v134 row_newbcast:4 row_mask:0xf bank_mask:0xf
    v_and_b32_dpp v59, v27, v135 row_newbcast:4 row_mask:0xf bank_mask:0xf
    v_and_b32_dpp v60, v27, v134 row_newbcast:8 row_mask:0xf bank_mask:0xf
    v_and_b32_dpp v61, v27, v135 row_newbcast:8 row_mask:0xf bank_mask:0xf
    v_and_b32_dpp v62, v27, v134 row_newbcast:12 row_mask:0xf bank_mask:0xf
    v_and_b32_dpp v63, v27, v135 row_newbcast:12 row_mask:0xf bank_mask:0xf
    v_add_f32_dpp v25, v25, v25 row_ror:4 row_mask:0xf bank_mask:0xf
    s_nop 1
    v_add_f32_dpp v25, v25, v25 row_ror:8 row_mask:0xf bank_mask:0xf
    v_mov_b32 v26, v25
    s_nop 1
    v_permlane16_swap_b32 v25, v26
    v_add_f32 v25, v25, v26
    v_mov_b32 v26, v25
    s_nop 1
    v_permlane32_swap_b32 v25, v26
    v_add_f32 v25, v25, v26
    s_waitcnt lgkmcnt(0)
    v_readfirstlane_b32 s3, v31
    s_mov_b64 exec, 1
    ds_write_b64 v11, v[24:25] offset:768
    s_mov_b64 exec, -1
    s_waitcnt vmcnt(7)
    v_mfma_f32_16x16x16_bf16 v[16:19], v[48:49], v[80:81], 0
    v_mfma_f32_16x16x16_bf16 v[24:27], v[48:49], v[82:83], 0
    s_waitcnt vmcnt(6)
    v_mfma_f32_16x16x16_bf16 v[16:19], v[50:51], v[84:85], v[16:19]
    v_mfma_f32_16x16x16_bf16 v[24:27], v[50:51], v[86:87], v[24:27]
    s_waitcnt vmcnt(5)
    v_mfma_f32_16x16x16_bf16 v[16:19], v[52:53], v[88:89], v[16:19]
    v_mfma_f32_16x16x16_bf16 v[24:27], v[52:53], v[90:91], v[24:27]
    s_waitcnt vmcnt(4)
    v_mfma_f32_16x16x16_bf16 v[16:19], v[54:55], v[92:93], v[16:19]
    v_mfma_f32_16x16x16_bf16 v[24:27], v[54:55], v[94:95], v[24:27]
    s_waitcnt vmcnt(3)
    v_mfma_f32_16x16x16_bf16 v[16:19], v[56:57], v[96:97], v[16:19]
    v_mfma_f32_16x16x16_bf16 v[24:27], v[56:57], v[98:99], v[24:27]
    s_waitcnt vmcnt(2)
    v_mfma_f32_16x16x16_bf16 v[16:19], v[58:59], v[100:101], v[16:19]
    v_mfma_f32_16x16x16_bf16 v[24:27], v[58:59], v[102:103], v[24:27]
L_pad4:
    s_cbranch_execz L_back
    buffer_load_dwordx4 v[112:115], v9, s[24:27], 0 offen offset:0 nt
    buffer_load_dwordx4 v[116:119], v9, s[24:27], 0 offen offset:1024 nt
    buffer_load_dwordx4 v[120:123], v8, s[28:31], 0 offen nt
    buffer_load_dwordx4 v[148:151], v14, s[40:43], s5 offen sc1
    s_waitcnt vmcnt(5)
    v_mfma_f32_16x16x16_bf16 v[16:19], v[60:61], v[104:105], v[16:19]
    v_mfma_f32_16x16x16_bf16 v[24:27], v[60:61], v[106:107], v[24:27]
    s_waitcnt vmcnt(4)
    v_mfma_f32_16x16x16_bf16 v[16:19], v[62:63], v[108:109], v[16:19]
    v_mfma_f32_16x16x16_bf16 v[24:27], v[62:63], v[110:111], v[24:27]
    s_mov_b64 exec, 0xffff
    v_cmp_eq_u32 vcc, 1, v1
    s_cmp_eq_u32 s3, 0
    s_nop 3
    ds_write_b128 v140, v[16:19] offset:1024
    ds_write_b128 v140, v[24:27] offset:1040
    s_mov_b64 exec, -1
    s_waitcnt lgkmcnt(0)
    s_barrier
    ds_read_b64 v[24:25], v142 offset:768
    ds_read_b64 v[16:17], v141 offset:1024
    ds_read_b32 v132, v132 offset:512
    ds_read_b32 v133, v133 offset:256
    s_waitcnt lgkmcnt(3)
    v_max_f32_dpp v26, v24, v24 quad_perm:[1,0,3,2] row_mask:0xf bank_mask:0xf
    s_nop 1
    v_max_f32_dpp v26, v26, v26 quad_perm:[2,3,0,1] row_mask:0xf bank_mask:0xf
    s_nop 1
    v_max_f32_dpp v26, v26, v26 row_half_mirror row_mask:0xf bank_mask:0xf
    v_sub_f32 v24, v24, v26
    v_mul_f32 v24, s59, v24
    v_exp_f32 v24, v24
    s_waitcnt lgkmcnt(2)
    v_mul_f32 v20, v24, v16
    v_mul_f32 v22, v24, v17
    v_mul_f32 v25, v24, v25
    v_add_f32_dpp v20, v20, v20 quad_perm:[1,0,3,2] row_mask:0xf bank_mask:0xf
    v_add_f32_dpp v22, v22, v22 quad_perm:[1,0,3,2] row_mask:0xf bank_mask:0xf
    v_add_f32_dpp v25, v25, v25 quad_perm:[1,0,3,2] row_mask:0xf bank_mask:0xf
    v_add_f32_dpp v20, v20, v20 quad_perm:[2,3,0,1] row_mask:0xf bank_mask:0xf
    v_add_f32_dpp v22, v22, v22 quad_perm:[2,3,0,1] row_mask:0xf bank_mask:0xf
    v_add_f32_dpp v25, v25, v25 quad_perm:[2,3,0,1] row_mask:0xf bank_mask:0xf
    v_add_f32_dpp v20, v20, v20 row_half_mirror row_mask:0xf bank_mask:0xf
    v_add_f32_dpp v22, v22, v22 row_half_mirror row_mask:0xf bank_mask:0xf
    v_add_f32_dpp v25, v25, v25 row_half_mirror row_mask:0xf bank_mask:0xf
    v_cndmask_b32 v20, v20, v26, vcc
    v_cndmask_b32 v22, v22, v25, vcc
    s_mov_b64 exec, s[90:91]
    s_cbranch_scc0 L_x2r
    buffer_store_dwordx4 v[20:23], v143, s[40:43], s5 offen
    s_branch L_x2e
L_x2r:
    buffer_store_dwordx4 v[20:23], v143, s[40:43], s5 offen sc1
L_x2e:
    s_mov_b64 exec, -1
    s_waitcnt lgkmcnt(0)
    v_and_b32 v32, v132, v4
    v_and_b32 v33, v132, v5
    v_and_b32 v34, v132, v6
    v_and_b32 v35, v132, v7
    s_waitcnt vmcnt(1)
    s_nop 0
    v_mfma_f32_16x16x32_bf16 v[24:27], v[32:35], v[120:123], 0
L_x2:
    buffer_load_dwordx4 v[148:151], v14, s[40:43], s5 offen sc1
    s_add_u32 s57, s57, 1
    s_cmp_gt_u32 s57, 200000
    s_cbranch_scc1 L_fin
    s_waitcnt vmcnt(0)
    v_xor_b32 v17, s48, v149
    v_bitop3_b32 v17, v151, s48, v17 bitop3:0xbe
    v_cmp_ne_u32 vcc, 0, v17
    s_nop 0
    s_mov_b64 exec, vcc
    s_cbranch_execnz L_x2
    s_mov_b64 exec, -1
    v_max_f32_dpp v16, v148, v148 quad_perm:[1,0,3,2] row_mask:0xf bank_mask:0xf
    v_mov_b32 v18, v148
    v_mov_b32 v19, v150
    v_max_f32_dpp v16, v16, v16 quad_perm:[2,3,0,1] row_mask:0xf bank_mask:0xf
    v_sub_f32 v16, v18, v16
    v_mul_f32 v16, s59, v16
    v_exp_f32 v16, v16
    s_nop 0
    v_mul_f32 v17, v16, v19
    v_mul_f32 v16, v16, v133
    s_nop 0
    v_add_f32_dpp v17, v17, v17 quad_perm:[1,0,3,2] row_mask:0xf bank_mask:0xf
    s_nop 1
    v_add_f32_dpp v17, v17, v17 quad_perm:[2,3,0,1] row_mask:0xf bank_mask:0xf
    v_rcp_f32 v17, v17
    s_nop 0
    v_mul_f32 v16, v16, v17
    s_nop 1
    v_mul_f32_dpp v18, v16, v18 row_shl:4 row_mask:0xf bank_mask:0xf bound_ctrl:0
    v_mul_f32_dpp v19, v16, v19 row_shl:4 row_mask:0xf bank_mask:0xf bound_ctrl:0
    s_nop 0
    v_add_f32_dpp v18, v18, v18 quad_perm:[1,0,3,2] row_mask:0xf bank_mask:0xf
    v_add_f32_dpp v19, v19, v19 quad_perm:[1,0,3,2] row_mask:0xf bank_mask:0xf
    s_nop 0
    v_add_f32_dpp v18, v18, v18 quad_perm:[2,3,0,1] row_mask:0xf bank_mask:0xf
    v_add_f32_dpp v19, v19, v19 quad_perm:[2,3,0,1] row_mask:0xf bank_mask:0xf
    v_cvt_pk_bf16_f32 v18, v18, v18
    v_cvt_pk_bf16_f32 v19, v19, v19
    s_cmp_lt_u32 s49, 2
    v_and_b32 v48, v18, v4
    v_and_b32 v49, v18, v5
    v_and_b32 v52, v19, v4
    v_and_b32 v53, v19, v5
    v_and_b32_dpp v50, v18, v6 row_shr:4 row_mask:0xf bank_mask:0xf bound_ctrl:0
    v_and_b32_dpp v51, v18, v7 row_shr:4 row_mask:0xf bank_mask:0xf bound_ctrl:0
    v_and_b32_dpp v54, v19, v6 row_shr:4 row_mask:0xf bank_mask:0xf bound_ctrl:0
    v_and_b32_dpp v55, v19, v7 row_shr:4 row_mask:0xf bank_mask:0xf bound_ctrl:0
    v_mfma_f32_16x16x32_bf16 v[24:27], v[48:51], v[112:115], v[24:27]
    s_nop 0
    v_mfma_f32_16x16x32_bf16 v[24:27], v[52:55], v[116:119], v[24:27]
    s_nop 7
    ds_write_b128 v144, v[24:27] offset:5632
    s_waitcnt lgkmcnt(0)
    s_barrier
    s_cbranch_scc0 L_fin
    ds_read_b64 v[80:81], v145 offset:5632
    ds_read_b64 v[82:83], v145 offset:6656
    ds_read_b64 v[84:85], v145 offset:7680
    ds_read_b64 v[86:87], v145 offset:8704
    ds_read_b64 v[88:89], v145 offset:9728
    ds_read_b64 v[90:91], v145 offset:10752
    ds_read_b64 v[92:93], v145 offset:11776
    ds_read_b64 v[94:95], v145 offset:12800
    s_waitcnt lgkmcnt(4)
    v_pk_add_f32 v[80:81], v[80:81], v[82:83]
    v_pk_add_f32 v[84:85], v[84:85], v[86:87]
    s_waitcnt lgkmcnt(0)
    v_pk_add_f32 v[88:89], v[88:89], v[90:91]
    v_pk_add_f32 v[92:93], v[92:93], v[94:95]
    v_pk_add_f32 v[80:81], v[80:81], v[84:85]
    v_pk_add_f32 v[88:89], v[88:89], v[92:93]
    v_add_f32 v20, v80, v88
    v_add_f32 v22, v81, v89
    buffer_store_dwordx4 v[20:23], v147, s[40:43], s96 offen sc1
    s_cmp_eq_u32 s49, 1
    s_cbranch_scc0 L_fin
    s_add_u32 s53, s56, 32768
    s_add_u32 s54, s56, 0
    v_and_b32 v10, 1, v0
    v_lshlrev_b32 v10, 2, v10
    s_waitcnt vmcnt(0)
L_x3:
    buffer_load_dwordx4 v[48:51], v146, s[40:43], s56 offen sc1
    buffer_load_dwordx4 v[52:55], v146, s[40:43], s53 offen sc1
    s_add_u32 s57, s57, 1
    s_cmp_gt_u32 s57, 400000
    s_cbranch_scc1 L_fin
    s_waitcnt vmcnt(0)
    v_xor_b32 v16, s48, v49
    v_bitop3_b32 v16, v51, s48, v16 bitop3:0xbe
    v_bitop3_b32 v16, v53, s48, v16 bitop3:0xbe
    v_bitop3_b32 v16, v55, s48, v16 bitop3:0xbe
    v_cmp_ne_u32 vcc, 0, v16
    s_nop 0
    s_mov_b64 exec, vcc
    s_cbranch_execnz L_x3
    s_mov_b64 exec, -1
    v_add_f32 v16, v48, v52
    v_add_f32 v17, v50, v54
    s_nop 0
    v_add_f32_dpp v16, v16, v16 quad_perm:[2,3,0,1] row_mask:0xf bank_mask:0xf
    v_add_f32_dpp v17, v17, v17 quad_perm:[2,3,0,1] row_mask:0xf bank_mask:0xf
    s_nop 0
    v_add_f32_dpp v16, v16, v16 row_ror:4 row_mask:0xf bank_mask:0xf
    v_add_f32_dpp v17, v17, v17 row_ror:4 row_mask:0xf bank_mask:0xf
    s_nop 0
    v_add_f32_dpp v16, v16, v16 row_ror:8 row_mask:0xf bank_mask:0xf
    v_add_f32_dpp v17, v17, v17 row_ror:8 row_mask:0xf bank_mask:0xf
    v_mov_b32 v18, v16
    v_mov_b32 v19, v17
    s_nop 0
    v_permlane16_swap_b32 v16, v18
L_pad5:
    s_cbranch_execz L_back
    v_permlane16_swap_b32 v17, v19
    v_add_f32 v16, v16, v18
    v_add_f32 v17, v17, v19
    v_mov_b32 v18, v16
    v_mov_b32 v19, v17
    s_nop 0
    v_permlane32_swap_b32 v16, v18
    v_permlane32_swap_b32 v17, v19
    v_add_f32 v16, v16, v18
    v_add_f32 v17, v17, v19
    v_cvt_pk_bf16_f32 v16, v16, v17
    s_mov_b64 exec, 3
    buffer_store_dword v16, v10, s[36:39], s97 offen
    s_cmp_eq_u32 s2, 0
    s_cbranch_scc0 L_fin
    s_mov_b64 exec, 1
    buffer_store_dword v21, v10, s[40:43], 0 offen sc1
L_fin:
L_end:
    s_endpgm
.section .rodata,"a"
.p2align 6
.amdhsa_kernel gated_mix__sliding_block_cached__glu_gated_bilinear__decode_kernel
  .amdhsa_next_free_vgpr 152
  .amdhsa_next_free_sgpr 98
  .amdhsa_accum_offset 152
  .amdhsa_group_segment_fixed_size 0
  .amdhsa_kernarg_size 104
  .amdhsa_user_sgpr_count 2
  .amdhsa_user_sgpr_kernarg_segment_ptr 1
  .amdhsa_system_sgpr_workgroup_id_x 1
.end_amdhsa_kernel
```
